```python
import torch

def _softmax(x, axis=-1):
    return torch.softmax(x, dim=axis)
def _gelu(x):
    return torch.nn.functional.gelu(x, approximate="tanh")
def _silu(x):
    return torch.nn.functional.silu(x)
def _sigmoid(x):
    return torch.sigmoid(x)
def _layernorm(x, axis=-1, eps=1e-5):
    m = x.mean(dim=axis, keepdim=True)
    v = x.var(dim=axis, keepdim=True, unbiased=False)
    return (x - m) / torch.sqrt(v + eps)
def _scatter_add(tgt, idx, src, axis=0):
    return tgt.clone().index_add_(axis, idx, src)
def _segment_sum(src, seg, n):
    out = torch.zeros((n,) + src.shape[1:], dtype=src.dtype)
    return out.index_add_(0, seg, src)
def _pad(x, pw):
    flat = tuple(v for pair in reversed(pw) for v in pair)
    return torch.nn.functional.pad(x, flat)

kernel_name = 'standalone__rezero__sampling'

def setup_inputs():

    _w = (lambda a: (lambda t: t.to(torch.bfloat16) if t.is_floating_point() else t)(torch.as_tensor(a)))
    B, S, D = 1024, 8, 512
    return {
        "x": _w((lambda *s: torch.randn(*s, dtype=torch.bfloat16) * 0.05)(B, S, D)),
        "fx": _w((lambda *s: torch.randn(*s, dtype=torch.bfloat16) * 1.6)(B, S, D)),
        "alpha": _w((lambda *s: torch.randn(*s, dtype=torch.bfloat16) * 1.6)(1) * 0.1),
    }

def reference(x, fx, alpha):
    return x + alpha * fx
```

```asm
; @launch grid=(512,1,1) block=(256,1,1) lds=0
.amdgcn_target "amdgcn-amd-amdhsa--gfx950"
.text
.globl standalone__rezero__sampling_kernel
.p2align 12
.p2align 8
.type standalone__rezero__sampling_kernel,@function
standalone__rezero__sampling_kernel:
    s_load_dwordx8 s[4:11], s[0:1], 0
    s_cmp_ge_u32 s2, 512
    s_cbranch_scc1 L_done
    s_lshl_b32 s3, s2, 14
    v_and_b32 v1, 63, v0
    v_lshrrev_b32 v2, 6, v0
    v_lshlrev_b32 v1, 4, v1
    v_lshlrev_b32 v2, 12, v2
    v_add3_u32 v1, v1, v2, s3
    s_waitcnt lgkmcnt(0)
    global_load_dwordx4 v[6:9], v1, s[6:7] nt
    global_load_dwordx4 v[2:5], v1, s[4:5] nt
    global_load_dwordx4 v[14:17], v1, s[6:7] offset:1024 nt
    global_load_dwordx4 v[10:13], v1, s[4:5] offset:1024 nt
    global_load_dwordx4 v[22:25], v1, s[6:7] offset:2048 nt
    global_load_dwordx4 v[18:21], v1, s[4:5] offset:2048 nt
    global_load_dwordx4 v[30:33], v1, s[6:7] offset:3072 nt
    global_load_dwordx4 v[26:29], v1, s[4:5] offset:3072 nt
    s_load_dword s12, s[8:9], 0
    s_waitcnt lgkmcnt(0)
    s_lshl_b32 s12, s12, 16
    s_mov_b32 s13, s12
    s_waitcnt vmcnt(7)
    v_lshlrev_b32 v34, 16, v6
    v_and_b32 v35, 0xffff0000, v6
    v_lshlrev_b32 v36, 16, v7
    v_and_b32 v37, 0xffff0000, v7
    v_lshlrev_b32 v38, 16, v8
    v_and_b32 v39, 0xffff0000, v8
    v_lshlrev_b32 v40, 16, v9
    v_and_b32 v41, 0xffff0000, v9
    v_pk_mul_f32 v[34:35], v[34:35], s[12:13]
    v_pk_mul_f32 v[36:37], v[36:37], s[12:13]
    v_pk_mul_f32 v[38:39], v[38:39], s[12:13]
    v_pk_mul_f32 v[40:41], v[40:41], s[12:13]
    v_cvt_pk_bf16_f32 v6, v34, v35
    v_cvt_pk_bf16_f32 v7, v36, v37
    v_cvt_pk_bf16_f32 v8, v38, v39
    v_cvt_pk_bf16_f32 v9, v40, v41
    v_lshlrev_b32 v34, 16, v6
    v_and_b32 v35, 0xffff0000, v6
    v_lshlrev_b32 v36, 16, v7
    v_and_b32 v37, 0xffff0000, v7
    v_lshlrev_b32 v38, 16, v8
    v_and_b32 v39, 0xffff0000, v8
    v_lshlrev_b32 v40, 16, v9
    v_and_b32 v41, 0xffff0000, v9
    s_waitcnt vmcnt(6)
    v_lshlrev_b32 v42, 16, v2
    v_and_b32 v43, 0xffff0000, v2
    v_lshlrev_b32 v44, 16, v3
    v_and_b32 v45, 0xffff0000, v3
    v_lshlrev_b32 v46, 16, v4
    v_and_b32 v47, 0xffff0000, v4
    v_lshlrev_b32 v48, 16, v5
    v_and_b32 v49, 0xffff0000, v5
    v_pk_add_f32 v[34:35], v[34:35], v[42:43]
    v_pk_add_f32 v[36:37], v[36:37], v[44:45]
    v_pk_add_f32 v[38:39], v[38:39], v[46:47]
    v_pk_add_f32 v[40:41], v[40:41], v[48:49]
    v_cvt_pk_bf16_f32 v2, v34, v35
    v_cvt_pk_bf16_f32 v3, v36, v37
    v_cvt_pk_bf16_f32 v4, v38, v39
    v_cvt_pk_bf16_f32 v5, v40, v41
    global_store_dwordx4 v1, v[2:5], s[10:11]
    s_waitcnt vmcnt(6)
    v_lshlrev_b32 v34, 16, v14
    v_and_b32 v35, 0xffff0000, v14
    v_lshlrev_b32 v36, 16, v15
    v_and_b32 v37, 0xffff0000, v15
    v_lshlrev_b32 v38, 16, v16
    v_and_b32 v39, 0xffff0000, v16
    v_lshlrev_b32 v40, 16, v17
    v_and_b32 v41, 0xffff0000, v17
    v_pk_mul_f32 v[34:35], v[34:35], s[12:13]
    v_pk_mul_f32 v[36:37], v[36:37], s[12:13]
    v_pk_mul_f32 v[38:39], v[38:39], s[12:13]
    v_pk_mul_f32 v[40:41], v[40:41], s[12:13]
    v_cvt_pk_bf16_f32 v14, v34, v35
    v_cvt_pk_bf16_f32 v15, v36, v37
    v_cvt_pk_bf16_f32 v16, v38, v39
    v_cvt_pk_bf16_f32 v17, v40, v41
    v_lshlrev_b32 v34, 16, v14
    v_and_b32 v35, 0xffff0000, v14
    v_lshlrev_b32 v36, 16, v15
    v_and_b32 v37, 0xffff0000, v15
    v_lshlrev_b32 v38, 16, v16
    v_and_b32 v39, 0xffff0000, v16
    v_lshlrev_b32 v40, 16, v17
    v_and_b32 v41, 0xffff0000, v17
    s_waitcnt vmcnt(5)
    v_lshlrev_b32 v42, 16, v10
    v_and_b32 v43, 0xffff0000, v10
    v_lshlrev_b32 v44, 16, v11
    v_and_b32 v45, 0xffff0000, v11
    v_lshlrev_b32 v46, 16, v12
    v_and_b32 v47, 0xffff0000, v12
    v_lshlrev_b32 v48, 16, v13
    v_and_b32 v49, 0xffff0000, v13
    v_pk_add_f32 v[34:35], v[34:35], v[42:43]
    v_pk_add_f32 v[36:37], v[36:37], v[44:45]
    v_pk_add_f32 v[38:39], v[38:39], v[46:47]
    v_pk_add_f32 v[40:41], v[40:41], v[48:49]
    v_cvt_pk_bf16_f32 v10, v34, v35
    v_cvt_pk_bf16_f32 v11, v36, v37
    v_cvt_pk_bf16_f32 v12, v38, v39
    v_cvt_pk_bf16_f32 v13, v40, v41
    global_store_dwordx4 v1, v[10:13], s[10:11] offset:1024
    s_waitcnt vmcnt(5)
    v_lshlrev_b32 v34, 16, v22
    v_and_b32 v35, 0xffff0000, v22
    v_lshlrev_b32 v36, 16, v23
    v_and_b32 v37, 0xffff0000, v23
    v_lshlrev_b32 v38, 16, v24
    v_and_b32 v39, 0xffff0000, v24
    v_lshlrev_b32 v40, 16, v25
    v_and_b32 v41, 0xffff0000, v25
    v_pk_mul_f32 v[34:35], v[34:35], s[12:13]
    v_pk_mul_f32 v[36:37], v[36:37], s[12:13]
    v_pk_mul_f32 v[38:39], v[38:39], s[12:13]
    v_pk_mul_f32 v[40:41], v[40:41], s[12:13]
    v_cvt_pk_bf16_f32 v22, v34, v35
    v_cvt_pk_bf16_f32 v23, v36, v37
    v_cvt_pk_bf16_f32 v24, v38, v39
    v_cvt_pk_bf16_f32 v25, v40, v41
    v_lshlrev_b32 v34, 16, v22
    v_and_b32 v35, 0xffff0000, v22
    v_lshlrev_b32 v36, 16, v23
    v_and_b32 v37, 0xffff0000, v23
    v_lshlrev_b32 v38, 16, v24
    v_and_b32 v39, 0xffff0000, v24
    v_lshlrev_b32 v40, 16, v25
    v_and_b32 v41, 0xffff0000, v25
    s_waitcnt vmcnt(4)
    v_lshlrev_b32 v42, 16, v18
    v_and_b32 v43, 0xffff0000, v18
    v_lshlrev_b32 v44, 16, v19
    v_and_b32 v45, 0xffff0000, v19
    v_lshlrev_b32 v46, 16, v20
    v_and_b32 v47, 0xffff0000, v20
    v_lshlrev_b32 v48, 16, v21
    v_and_b32 v49, 0xffff0000, v21
    v_pk_add_f32 v[34:35], v[34:35], v[42:43]
    v_pk_add_f32 v[36:37], v[36:37], v[44:45]
    v_pk_add_f32 v[38:39], v[38:39], v[46:47]
    v_pk_add_f32 v[40:41], v[40:41], v[48:49]
    v_cvt_pk_bf16_f32 v18, v34, v35
    v_cvt_pk_bf16_f32 v19, v36, v37
    v_cvt_pk_bf16_f32 v20, v38, v39
    v_cvt_pk_bf16_f32 v21, v40, v41
    global_store_dwordx4 v1, v[18:21], s[10:11] offset:2048
    s_waitcnt vmcnt(4)
    v_lshlrev_b32 v34, 16, v30
    v_and_b32 v35, 0xffff0000, v30
    v_lshlrev_b32 v36, 16, v31
    v_and_b32 v37, 0xffff0000, v31
    v_lshlrev_b32 v38, 16, v32
    v_and_b32 v39, 0xffff0000, v32
    v_lshlrev_b32 v40, 16, v33
    v_and_b32 v41, 0xffff0000, v33
    v_pk_mul_f32 v[34:35], v[34:35], s[12:13]
    v_pk_mul_f32 v[36:37], v[36:37], s[12:13]
    v_pk_mul_f32 v[38:39], v[38:39], s[12:13]
    v_pk_mul_f32 v[40:41], v[40:41], s[12:13]
    v_cvt_pk_bf16_f32 v30, v34, v35
    v_cvt_pk_bf16_f32 v31, v36, v37
    v_cvt_pk_bf16_f32 v32, v38, v39
    v_cvt_pk_bf16_f32 v33, v40, v41
    v_lshlrev_b32 v34, 16, v30
    v_and_b32 v35, 0xffff0000, v30
    v_lshlrev_b32 v36, 16, v31
    v_and_b32 v37, 0xffff0000, v31
    v_lshlrev_b32 v38, 16, v32
    v_and_b32 v39, 0xffff0000, v32
    v_lshlrev_b32 v40, 16, v33
    v_and_b32 v41, 0xffff0000, v33
    s_waitcnt vmcnt(3)
    v_lshlrev_b32 v42, 16, v26
    v_and_b32 v43, 0xffff0000, v26
    v_lshlrev_b32 v44, 16, v27
    v_and_b32 v45, 0xffff0000, v27
    v_lshlrev_b32 v46, 16, v28
    v_and_b32 v47, 0xffff0000, v28
    v_lshlrev_b32 v48, 16, v29
    v_and_b32 v49, 0xffff0000, v29
    v_pk_add_f32 v[34:35], v[34:35], v[42:43]
    v_pk_add_f32 v[36:37], v[36:37], v[44:45]
    v_pk_add_f32 v[38:39], v[38:39], v[46:47]
    v_pk_add_f32 v[40:41], v[40:41], v[48:49]
    v_cvt_pk_bf16_f32 v26, v34, v35
    v_cvt_pk_bf16_f32 v27, v36, v37
    v_cvt_pk_bf16_f32 v28, v38, v39
    v_cvt_pk_bf16_f32 v29, v40, v41
    global_store_dwordx4 v1, v[26:29], s[10:11] offset:3072
L_done:
    s_endpgm
.section .rodata,"a"
.p2align 6
.amdhsa_kernel standalone__rezero__sampling_kernel
  .amdhsa_next_free_vgpr 50
  .amdhsa_next_free_sgpr 16
  .amdhsa_accum_offset 52
  .amdhsa_group_segment_fixed_size 0
  .amdhsa_kernarg_size 48
  .amdhsa_user_sgpr_count 2
  .amdhsa_user_sgpr_kernarg_segment_ptr 1
  .amdhsa_system_sgpr_workgroup_id_x 1
  .amdhsa_float_denorm_mode_32 3
.end_amdhsa_kernel
```
